```python
import torch

def _softmax(x, axis=-1):
    return torch.softmax(x, dim=axis)
def _gelu(x):
    return torch.nn.functional.gelu(x, approximate="tanh")
def _silu(x):
    return torch.nn.functional.silu(x)
def _sigmoid(x):
    return torch.sigmoid(x)
def _layernorm(x, axis=-1, eps=1e-5):
    m = x.mean(dim=axis, keepdim=True)
    v = x.var(dim=axis, keepdim=True, unbiased=False)
    return (x - m) / torch.sqrt(v + eps)
def _scatter_add(tgt, idx, src, axis=0):
    return tgt.clone().index_add_(axis, idx, src)
def _segment_sum(src, seg, n):
    out = torch.zeros((n,) + src.shape[1:], dtype=src.dtype)
    return out.index_add_(0, seg, src)
def _pad(x, pw):
    flat = tuple(v for pair in reversed(pw) for v in pair)
    return torch.nn.functional.pad(x, flat)

kernel_name = 'parallel_sum__sliding_block_cached__swiglu_ffn__decode'

def setup_inputs():

    _w = (lambda a: (lambda t: t.to(torch.bfloat16) if t.is_floating_point() else t)(torch.as_tensor(a)))
    def _A_setup():
        B, Sq, D = 4, 1, 512
        Hq, Hkv, Sk, Dh = 32, 8, 16384, 128
        assert Hq % Hkv == 0, (Hq, Hkv)
        return {
            "x": _w((lambda *s: torch.randn(*s, dtype=torch.bfloat16) * 0.05)(B, Sq, D)),
            "k_cache": _w((lambda *s: torch.randn(*s, dtype=torch.bfloat16) * 3.2)(B, Hkv, Sk, Dh)),
            "v_cache": _w((lambda *s: torch.randn(*s, dtype=torch.bfloat16) * 1.6)(B, Hkv, Sk, Dh)),
            "wq": _w((lambda *s: torch.randn(*s, dtype=torch.bfloat16) * 3.2)(D, Hq * Dh) * (D ** -0.5)),
            "wo": _w((lambda *s: torch.randn(*s, dtype=torch.bfloat16) * 1.6)(Hq * Dh, D) * ((Hq * Dh) ** -0.5)),
        }
    _A_in = _A_setup()

    def _B_setup():
        B, S, D, F = 4, 1, 512, 1792
        return {
            "x": _w((lambda *s: torch.randn(*s, dtype=torch.bfloat16) * 0.05)(B, S, D)),
            "w_gate": _w((lambda *s: torch.randn(*s, dtype=torch.bfloat16) * 0.05)(D, F)),
            "w_up": _w((lambda *s: torch.randn(*s, dtype=torch.bfloat16) * 0.05)(D, F)),
            "w_down": _w((lambda *s: torch.randn(*s, dtype=torch.bfloat16) * 0.05)(F, D)),
        }
    _B_in = _B_setup()

    return {
        "A_x": _A_in["x"],
        "A_k_cache": _A_in["k_cache"],
        "A_v_cache": _A_in["v_cache"],
        "A_wq": _A_in["wq"],
        "A_wo": _A_in["wo"],
        "B_x": _B_in["x"],
        "B_w_gate": _B_in["w_gate"],
        "B_w_up": _B_in["w_up"],
        "B_w_down": _B_in["w_down"],
    }

def reference(A_x, A_k_cache, A_v_cache, A_wq, A_wo, B_x, B_w_gate, B_w_up, B_w_down):
    def _A_ref(x, k_cache, v_cache, wq, wo):
        B, Sq, D = x.shape
        Hq, Dh = 32, 128
        Hkv, Sk = k_cache.shape[1], k_cache.shape[2]
        W = min(4096, max(256, Sk // 4))
        rep = Hq // Hkv
        q = (lambda x, *d: x.permute(*d))((x @ wq).reshape(B, Sq, Hq, Dh), 0, 2, 1, 3)
        k = (lambda x, n, axis: torch.repeat_interleave(x, n, dim=axis))(k_cache[:, :, Sk - W:, :], rep, axis=1)
        v = (lambda x, n, axis: torch.repeat_interleave(x, n, dim=axis))(v_cache[:, :, Sk - W:, :], rep, axis=1)
        scores = torch.einsum("bhqd,bhkd->bhqk", q, k) * (Dh ** -0.5)
        p = _softmax(scores, axis=-1)
        o = torch.einsum("bhqk,bhkd->bhqd", p, v)
        return (lambda x, *d: x.permute(*d))(o, 0, 2, 1, 3).reshape(B, Sq, Hq * Dh) @ wo

    def _B_ref(x, w_gate, w_up, w_down):
        g = _silu(x @ w_gate)
        u = x @ w_up
        return (g * u) @ w_down

    x = A_x
    xn = _layernorm(x, axis=-1)
    return x + _A_ref(xn, A_k_cache, A_v_cache, A_wq, A_wo) + _B_ref(xn, B_w_gate, B_w_up, B_w_down)
```

```asm
; @launch grid=(256,1,1) block=(512,1,1) lds=13440
.amdgcn_target "amdgcn-amd-amdhsa--gfx950"
.text
.p2align 12
.fill 832, 4, 0xbf810000
.globl parallel_sum__sliding_block_cached__swiglu_ffn__decode_kernel
.p2align 8
.type parallel_sum__sliding_block_cached__swiglu_ffn__decode_kernel,@function
parallel_sum__sliding_block_cached__swiglu_ffn__decode_kernel:
s_load_dwordx16 s[8:23], s[0:1], 0
s_load_dwordx8 s[24:31], s[0:1], 64
s_cmp_ge_u32 s2, 256
s_cbranch_scc1 L_end
v_lshrrev_b32 v1, 6, v0
v_and_b32 v0, 63, v0
v_readfirstlane_b32 s3, v1
s_and_b32 s4, s2, 7
s_lshr_b32 s5, s2, 3
v_and_b32 v2, 15, v0
v_lshrrev_b32 v3, 4, v0
v_bfe_u32 v4, v0, 2, 2
v_and_b32 v5, 3, v0
s_lshr_b32 s6, s5, 3
s_and_b32 s7, s5, 7
s_cmp_ge_u32 s3, 4
s_cbranch_scc1 L_stream
s_mov_b32 s62, s5
s_mul_i32 s35, s4, 7
s_add_u32 s35, s35, 1
s_lshr_b32 s35, s35, 1
s_mul_i32 s35, s35, 0x01010101
s_add_u32 s35, s35, 0x03020100
s_and_b32 s34, s62, 1
s_lshr_b32 s40, s62, 1
s_lshl_b32 s41, s4, 3
s_add_u32 s41, s41, s40
s_lshl_b32 s42, s62, 1
s_and_b32 s42, s42, 24
s_lshr_b32 s42, s35, s42
s_and_b32 s42, s42, 31
s_cmp_lt_u32 s62, 16
s_cselect_b32 s33, s41, s42
s_movk_i32 s43, 3584
s_cselect_b32 s32, 8192, s43
s_lshl_b32 s40, s3, 10
v_lshl_add_u32 v6, v0, 4, s40
s_lshl_b32 s40, s34, 2
s_add_u32 s40, s40, s3
s_lshl_b32 s40, s40, 6
v_lshl_add_u32 v7, v3, 4, s40
v_lshlrev_b32 v8, 1, v7
v_lshl_add_u32 v8, v4, 10, v8
s_lshl_b32 s41, s33, 7
v_lshl_add_u32 v9, v2, 3, s41
v_mad_u32_u24 v9, v7, s32, v9
s_getreg_b32 s36, hwreg(HW_REG_XCC_ID, 0, 4)
s_bitset1_b32 s36, 7
s_lshl_b32 s42, s4, 5
s_add_u32 s43, s42, s5
v_mov_b32 v10, s43
v_mov_b32 v11, s36
v_and_b32 v12, 7, v0
v_lshl_add_u32 v12, v12, 2, s42
s_lshl_b32 s57, s62, 3
s_or_b32 s57, s57, s4
s_and_b32 s57, s57, 0xe1
s_bitcmp1_b32 s62, 1
s_mov_b64 exec, 1
s_waitcnt lgkmcnt(0)
global_store_byte v10, v11, s[28:29]
s_mov_b64 exec, -1
global_load_dwordx4 v[16:19], v6, s[8:9]
s_cselect_b64 s[50:51], s[22:23], s[20:21]
s_cmp_lt_u32 s62, 16
s_cselect_b64 s[50:51], s[14:15], s[50:51]
s_load_dword s56, s[30:31], 0x81000
s_cmp_eq_u32 s57, 0xe1
s_cbranch_scc1 L_noA
global_load_dwordx2 v[40:41], v9, s[50:51] nt
v_add_u32 v9, s32, v9
global_load_dwordx2 v[42:43], v9, s[50:51] nt
v_add_u32 v9, s32, v9
global_load_dwordx2 v[44:45], v9, s[50:51] nt
v_add_u32 v9, s32, v9
global_load_dwordx2 v[46:47], v9, s[50:51] nt
v_add_u32 v9, s32, v9
global_load_dwordx2 v[48:49], v9, s[50:51] nt
v_add_u32 v9, s32, v9
global_load_dwordx2 v[50:51], v9, s[50:51] nt
v_add_u32 v9, s32, v9
global_load_dwordx2 v[52:53], v9, s[50:51] nt
v_add_u32 v9, s32, v9
global_load_dwordx2 v[54:55], v9, s[50:51] nt
v_add_u32 v9, s32, v9
global_load_dwordx2 v[56:57], v9, s[50:51] nt
v_add_u32 v9, s32, v9
global_load_dwordx2 v[58:59], v9, s[50:51] nt
v_add_u32 v9, s32, v9
global_load_dwordx2 v[60:61], v9, s[50:51] nt
v_add_u32 v9, s32, v9
global_load_dwordx2 v[62:63], v9, s[50:51] nt
v_add_u32 v9, s32, v9
global_load_dwordx2 v[64:65], v9, s[50:51] nt
v_add_u32 v9, s32, v9
global_load_dwordx2 v[66:67], v9, s[50:51] nt
v_add_u32 v9, s32, v9
global_load_dwordx2 v[68:69], v9, s[50:51] nt
v_add_u32 v9, s32, v9
global_load_dwordx2 v[70:71], v9, s[50:51] nt
s_mov_b32 s39, 0xffff0000
s_mov_b32 s37, 0x05040100
s_mov_b32 s38, 0x07060302
s_mov_b32 s53, 0x3fb8aa3b
v_mov_b32 v15, 13380
v_mov_b32 v13, 0
ds_write_b32 v15, v13
s_waitcnt vmcnt(16)
v_lshlrev_b32 v72, 16, v16
v_and_b32 v73, s39, v16
v_lshlrev_b32 v74, 16, v17
v_and_b32 v75, s39, v17
v_lshlrev_b32 v76, 16, v18
v_and_b32 v77, s39, v18
v_lshlrev_b32 v78, 16, v19
v_and_b32 v79, s39, v19
v_pk_add_f32 v[32:33], v[72:73], v[74:75]
v_pk_add_f32 v[34:35], v[76:77], v[78:79]
v_pk_add_f32 v[32:33], v[32:33], v[34:35]
v_add_f32 v10, v32, v33
s_nop 1
v_add_f32_dpp v10, v10, v10 quad_perm:[1,0,3,2] row_mask:0xf bank_mask:0xf
s_nop 1
v_add_f32_dpp v10, v10, v10 quad_perm:[2,3,0,1] row_mask:0xf bank_mask:0xf
s_nop 1
v_add_f32_dpp v10, v10, v10 row_ror:8 row_mask:0xf bank_mask:0xf
s_nop 1
v_add_f32_dpp v10, v10, v10 row_ror:4 row_mask:0xf bank_mask:0xf
v_mov_b32 v36, v10
s_nop 1
v_permlane16_swap_b32 v10, v36
v_add_f32 v10, v10, v36
v_mov_b32 v36, v10
s_nop 1
v_permlane32_swap_b32 v10, v36
v_add_f32 v10, v10, v36
v_mul_f32 v10, 0x3b000000, v10
v_pk_add_f32 v[80:81], v[72:73], v[10:11] op_sel_hi:[1,0] neg_lo:[0,1] neg_hi:[0,1]
v_pk_add_f32 v[82:83], v[74:75], v[10:11] op_sel_hi:[1,0] neg_lo:[0,1] neg_hi:[0,1]
v_pk_add_f32 v[84:85], v[76:77], v[10:11] op_sel_hi:[1,0] neg_lo:[0,1] neg_hi:[0,1]
v_pk_add_f32 v[86:87], v[78:79], v[10:11] op_sel_hi:[1,0] neg_lo:[0,1] neg_hi:[0,1]
v_pk_mul_f32 v[32:33], v[80:81], v[80:81]
v_pk_mul_f32 v[34:35], v[82:83], v[82:83]
v_pk_fma_f32 v[32:33], v[84:85], v[84:85], v[32:33]
v_pk_fma_f32 v[34:35], v[86:87], v[86:87], v[34:35]
v_pk_add_f32 v[32:33], v[32:33], v[34:35]
v_add_f32 v11, v32, v33
s_nop 1
v_add_f32_dpp v11, v11, v11 quad_perm:[1,0,3,2] row_mask:0xf bank_mask:0xf
s_nop 1
v_add_f32_dpp v11, v11, v11 quad_perm:[2,3,0,1] row_mask:0xf bank_mask:0xf
s_nop 1
v_add_f32_dpp v11, v11, v11 row_ror:8 row_mask:0xf bank_mask:0xf
s_nop 1
v_add_f32_dpp v11, v11, v11 row_ror:4 row_mask:0xf bank_mask:0xf
v_mov_b32 v36, v11
s_nop 1
v_permlane16_swap_b32 v11, v36
v_add_f32 v11, v11, v36
v_mov_b32 v36, v11
s_nop 1
v_permlane32_swap_b32 v11, v36
v_add_f32 v11, v11, v36
v_mul_f32 v11, 0x3b000000, v11
v_cvt_pk_bf16_f32 v13, v10, v11
v_lshlrev_b32 v10, 16, v13
v_and_b32 v11, s39, v13
v_add_f32 v11, 0x3727c5ac, v11
v_pk_add_f32 v[72:73], v[72:73], v[10:11] op_sel_hi:[1,0] neg_lo:[0,1] neg_hi:[0,1]
v_pk_add_f32 v[74:75], v[74:75], v[10:11] op_sel_hi:[1,0] neg_lo:[0,1] neg_hi:[0,1]
v_pk_add_f32 v[76:77], v[76:77], v[10:11] op_sel_hi:[1,0] neg_lo:[0,1] neg_hi:[0,1]
v_pk_add_f32 v[78:79], v[78:79], v[10:11] op_sel_hi:[1,0] neg_lo:[0,1] neg_hi:[0,1]
v_cvt_pk_bf16_f32 v11, v11, v11
v_lshlrev_b32 v11, 16, v11
v_sqrt_f32 v11, v11
v_cvt_pk_bf16_f32 v16, v72, v73
v_cvt_pk_bf16_f32 v17, v74, v75
v_cvt_pk_bf16_f32 v18, v76, v77
v_cvt_pk_bf16_f32 v19, v78, v79
v_cvt_pk_bf16_f32 v11, v11, v11
v_lshlrev_b32 v11, 16, v11
v_rcp_f32 v10, v11
v_lshlrev_b32 v72, 16, v16
v_and_b32 v73, s39, v16
v_lshlrev_b32 v74, 16, v17
v_and_b32 v75, s39, v17
v_lshlrev_b32 v76, 16, v18
v_and_b32 v77, s39, v18
v_lshlrev_b32 v78, 16, v19
v_and_b32 v79, s39, v19
v_pk_mul_f32 v[72:73], v[72:73], v[10:11] op_sel_hi:[1,0]
v_pk_mul_f32 v[74:75], v[74:75], v[10:11] op_sel_hi:[1,0]
v_pk_mul_f32 v[76:77], v[76:77], v[10:11] op_sel_hi:[1,0]
v_pk_mul_f32 v[78:79], v[78:79], v[10:11] op_sel_hi:[1,0]
v_cvt_pk_bf16_f32 v16, v72, v73
v_cvt_pk_bf16_f32 v17, v74, v75
v_cvt_pk_bf16_f32 v18, v76, v77
v_cvt_pk_bf16_f32 v19, v78, v79
ds_write_b128 v6, v[16:19] offset:4096
s_waitcnt lgkmcnt(0)
s_barrier
global_load_dword v14, v12, s[28:29] sc1
ds_read_b128 v[104:107], v8 offset:4096
ds_read_b128 v[108:111], v8 offset:4112
s_waitcnt lgkmcnt(0)
s_waitcnt vmcnt(9)
v_perm_b32 v112, v42, v40, s37
v_perm_b32 v113, v46, v44, s37
v_perm_b32 v114, v50, v48, s37
v_perm_b32 v115, v54, v52, s37
v_perm_b32 v116, v42, v40, s38
v_perm_b32 v117, v46, v44, s38
v_perm_b32 v118, v50, v48, s38
v_perm_b32 v119, v54, v52, s38
v_perm_b32 v120, v43, v41, s37
v_perm_b32 v121, v47, v45, s37
v_perm_b32 v122, v51, v49, s37
v_perm_b32 v123, v55, v53, s37
v_perm_b32 v124, v43, v41, s38
v_perm_b32 v125, v47, v45, s38
v_perm_b32 v126, v51, v49, s38
v_perm_b32 v127, v55, v53, s38
v_mfma_f32_16x16x32_bf16 v[144:147], v[104:107], v[112:115], 0
v_mfma_f32_16x16x32_bf16 v[148:151], v[104:107], v[116:119], 0
v_mfma_f32_16x16x32_bf16 v[152:155], v[104:107], v[120:123], 0
v_mfma_f32_16x16x32_bf16 v[156:159], v[104:107], v[124:127], 0
s_waitcnt vmcnt(1)
v_perm_b32 v128, v58, v56, s37
v_perm_b32 v129, v62, v60, s37
v_perm_b32 v130, v66, v64, s37
v_perm_b32 v131, v70, v68, s37
v_perm_b32 v132, v58, v56, s38
v_perm_b32 v133, v62, v60, s38
v_perm_b32 v134, v66, v64, s38
v_perm_b32 v135, v70, v68, s38
v_perm_b32 v136, v59, v57, s37
v_perm_b32 v137, v63, v61, s37
v_perm_b32 v138, v67, v65, s37
v_perm_b32 v139, v71, v69, s37
v_perm_b32 v140, v59, v57, s38
v_perm_b32 v141, v63, v61, s38
v_perm_b32 v142, v67, v65, s38
v_perm_b32 v143, v71, v69, s38
v_mfma_f32_16x16x32_bf16 v[144:147], v[108:111], v[128:131], v[144:147]
v_mfma_f32_16x16x32_bf16 v[148:151], v[108:111], v[132:135], v[148:151]
v_mfma_f32_16x16x32_bf16 v[152:155], v[108:111], v[136:139], v[152:155]
v_mfma_f32_16x16x32_bf16 v[156:159], v[108:111], v[140:143], v[156:159]
s_nop 5
ds_write2_b32 v6, v144, v148 offset0:0 offset1:1
s_nop 0
ds_write2_b32 v6, v152, v156 offset0:2 offset1:3
v_mov_b32 v13, 1
s_mov_b64 exec, 1
ds_add_u32 v15, v13
s_mov_b64 exec, -1
s_branch L_B0s
L_noA:
s_mov_b32 s39, 0xffff0000
s_mov_b32 s37, 0x05040100
s_mov_b32 s38, 0x07060302
s_mov_b32 s53, 0x3fb8aa3b
s_waitcnt vmcnt(0)
s_barrier
global_load_dword v14, v12, s[28:29] sc1
L_B0s:
s_waitcnt lgkmcnt(0)
s_mul_i32 s56, s56, 0x0019660d
s_add_u32 s56, s56, 0x3c6ef35f
s_mul_i32 s40, s36, 0x01010101
s_cmp_eq_u32 s3, 1
s_cbranch_scc1 L_w1a
s_cmp_eq_u32 s3, 2
s_cbranch_scc1 L_w2a
s_waitcnt vmcnt(0)
v_cmp_ne_u32 vcc, s40, v14
s_mov_b32 s45, vcc_lo
s_cmp_eq_u32 s3, 3
s_cbranch_scc1 L_clear
s_cmp_eq_u32 s57, 0xe1
s_cbranch_scc1 L_qduty
L_cnt:
ds_read_b32 v13, v15
s_waitcnt lgkmcnt(0)
v_cmp_ne_u32 vcc, 4, v13
s_nop 0
s_cbranch_vccnz L_cnt
v_lshlrev_b32 v10, 4, v0
ds_read_b128 v[16:19], v10 offset:0
ds_read_b128 v[20:23], v10 offset:1024
ds_read_b128 v[24:27], v10 offset:2048
ds_read_b128 v[28:31], v10 offset:3072
s_lshl_b32 s40, s4, 15
s_lshl_b32 s41, s34, 12
s_add_u32 s41, s40, s41
s_and_b32 s42, s33, 7
s_lshl_b32 s42, s42, 9
s_add_u32 s41, s41, s42
v_lshl_add_u32 v11, v2, 4, s41
v_lshl_add_u32 v11, v3, 13, v11
v_add_u32 v12, 256, v11
s_cmp_lt_u32 s62, 16
s_cbranch_scc1 L_pubq
s_bfe_u32 s41, s62, 0x20002
s_lshl_b32 s41, s41, 13
s_add_u32 s40, s40, s41
s_and_b32 s41, s62, 3
s_lshl_b32 s41, s41, 8
s_add_u32 s40, s40, s41
s_add_u32 s40, s40, 262144
v_lshl_add_u32 v11, v4, 11, s40
v_lshl_add_u32 v11, v3, 6, v11
v_lshl_add_u32 v11, v5, 4, v11
v_add_u32 v12, 1024, v11
L_pubq:
v_mov_b32 v33, s56
v_mov_b32 v35, s56
v_mov_b32 v37, s56
v_mov_b32 v39, s56
s_cmp_eq_u32 s45, 0
s_waitcnt lgkmcnt(0)
v_pk_add_f32 v[16:17], v[16:17], v[20:21]
v_pk_add_f32 v[24:25], v[24:25], v[28:29]
v_pk_add_f32 v[18:19], v[18:19], v[22:23]
v_pk_add_f32 v[26:27], v[26:27], v[30:31]
v_add_f32 v32, v16, v24
v_add_f32 v34, v17, v25
v_add_f32 v36, v18, v26
v_add_f32 v38, v19, v27
s_cbranch_scc0 L_slow_1
global_store_dwordx4 v11, v[32:35], s[30:31]
global_store_dwordx4 v12, v[36:39], s[30:31]
s_branch L_sdone_2
L_slow_1:
global_store_dwordx4 v11, v[32:35], s[30:31] sc1
global_store_dwordx4 v12, v[36:39], s[30:31] sc1
L_sdone_2:
s_waitcnt vmcnt(0)
L_qduty:
s_lshl_b32 s40, s4, 2
s_add_u32 s40, s40, s6
s_lshl_b32 s40, s40, 13
s_add_u32 s40, s40, 4096
v_lshl_add_u32 v10, v0, 4, s40
s_mov_b32 s44, 4194304
L_poll_3:
global_load_dwordx4 v[72:75], v10, s[30:31] offset:-4096 sc1
global_load_dwordx4 v[76:79], v10, s[30:31] offset:-3072 sc1
global_load_dwordx4 v[80:83], v10, s[30:31] offset:-2048 sc1
global_load_dwordx4 v[84:87], v10, s[30:31] offset:-1024 sc1
global_load_dwordx4 v[88:91], v10, s[30:31] offset:0 sc1
global_load_dwordx4 v[92:95], v10, s[30:31] offset:1024 sc1
global_load_dwordx4 v[96:99], v10, s[30:31] offset:2048 sc1
global_load_dwordx4 v[100:103], v10, s[30:31] offset:3072 sc1
s_waitcnt vmcnt(0)
v_xor_b32 v11, s56, v73
v_bitop3_b32 v11, v75, s56, v11 bitop3:0xbe
v_bitop3_b32 v11, v77, s56, v11 bitop3:0xbe
v_bitop3_b32 v11, v79, s56, v11 bitop3:0xbe
v_bitop3_b32 v11, v81, s56, v11 bitop3:0xbe
v_bitop3_b32 v11, v83, s56, v11 bitop3:0xbe
v_bitop3_b32 v11, v85, s56, v11 bitop3:0xbe
v_bitop3_b32 v11, v87, s56, v11 bitop3:0xbe
v_bitop3_b32 v11, v89, s56, v11 bitop3:0xbe
v_bitop3_b32 v11, v91, s56, v11 bitop3:0xbe
v_bitop3_b32 v11, v93, s56, v11 bitop3:0xbe
v_bitop3_b32 v11, v95, s56, v11 bitop3:0xbe
v_bitop3_b32 v11, v97, s56, v11 bitop3:0xbe
v_bitop3_b32 v11, v99, s56, v11 bitop3:0xbe
v_bitop3_b32 v11, v101, s56, v11 bitop3:0xbe
v_bitop3_b32 v11, v103, s56, v11 bitop3:0xbe
v_cmp_ne_u32 vcc, 0, v11
s_nop 0
s_cbranch_vccz L_pdone_4
s_mov_b64 exec, vcc
s_sub_u32 s44, s44, 1
s_cbranch_scc0 L_poll_3
L_pdone_4:
s_mov_b64 exec, -1
v_add_f32 v72, v72, v88
v_add_f32 v74, v74, v90
v_add_f32 v76, v76, v92
v_add_f32 v78, v78, v94
v_add_f32 v80, v80, v96
v_add_f32 v82, v82, v98
v_add_f32 v84, v84, v100
v_add_f32 v86, v86, v102
v_cvt_pk_bf16_f32 v16, v72, v74
v_cvt_pk_bf16_f32 v17, v76, v78
v_cvt_pk_bf16_f32 v18, v80, v82
v_cvt_pk_bf16_f32 v19, v84, v86
v_and_b32 v10, 32, v0
v_and_b32 v11, 1, v3
v_add_u32 v10, v10, v11
v_lshl_add_u32 v10, v2, 1, v10
v_lshlrev_b32 v10, 2, v10
ds_write2st64_b32 v10, v16, v17 offset0:48 offset1:49
ds_write2st64_b32 v10, v18, v19 offset0:50 offset1:51
s_branch L_B1s
L_w1a:
s_cmp_lg_u32 s5, 31
s_cbranch_scc1 L_B1s
s_getpc_b64 s[48:49]
L_pc:
v_lshlrev_b32 v10, 7, v0
v_add_u32 v11, 0x2000, v10
v_min_u32 v10, L_end-L_pc, v10
v_min_u32 v11, L_end-L_pc, v11
global_load_dword v250, v10, s[48:49]
global_load_dword v251, v11, s[48:49]
s_branch L_B1s
L_w2a:
s_cmp_lg_u32 s5, 0
s_cbranch_scc1 L_B1s
v_mov_b32 v72, 0
v_mov_b32 v73, 0
v_mov_b32 v74, 0
v_mov_b32 v75, 0
s_lshl_b32 s40, s4, 13
s_add_u32 s40, s40, 1048576
v_lshrrev_b32 v76, 2, v0
v_lshl_add_u32 v76, v76, 8, s40
v_lshl_add_u32 v76, v5, 4, v76
v_add_u32 v77, 4096, v76
global_store_dwordx4 v76, v[72:75], s[30:31] sc1
global_store_dwordx4 v77, v[72:75], s[30:31] sc1
s_lshl_b32 s40, s4, 7
s_add_u32 s40, s40, 532480
v_lshl_add_u32 v12, v2, 2, s40
v_mov_b32 v13, s56
s_waitcnt vmcnt(0)
s_mov_b64 exec, 0xffff
global_store_dword v12, v13, s[30:31] sc1
s_mov_b64 exec, -1
s_branch L_B1s
L_clear:
v_mov_b32 v13, s45
v_mov_b32 v15, 13376
ds_write_b32 v15, v13
v_mov_b32 v16, -1
v_mov_b32 v17, -1
v_mov_b32 v18, -1
v_mov_b32 v19, -1
s_lshl_b32 s40, s4, 15
s_lshl_b32 s41, s5, 6
s_add_u32 s40, s40, s41
s_add_u32 s40, s40, 589824
v_lshrrev_b32 v10, 2, v0
v_lshl_add_u32 v10, v10, 11, s40
v_lshl_add_u32 v10, v5, 4, v10
s_lshl_b32 s40, s4, 12
s_lshl_b32 s41, s5, 5
s_add_u32 s40, s40, s41
s_add_u32 s40, s40, 557056
v_bfe_u32 v11, v0, 3, 2
v_and_b32 v12, 7, v0
v_lshl_add_u32 v11, v11, 10, s40
v_lshl_add_u32 v11, v12, 2, v11
s_lshl_b32 s41, s4, 5
s_add_u32 s41, s41, s5
s_lshl_b32 s41, s41, 2
s_add_u32 s41, s41, 524288
v_mov_b32 v12, s41
v_mov_b32 v13, s56
s_cmp_eq_u32 s45, 0
s_cbranch_scc0 L_slow_5
global_store_dwordx4 v10, v[16:19], s[30:31]
global_store_dword v11, v16, s[30:31]
s_branch L_sdone_6
L_slow_5:
global_store_dwordx4 v10, v[16:19], s[30:31] sc1
global_store_dword v11, v16, s[30:31] sc1
L_sdone_6:
s_waitcnt vmcnt(0)
s_mov_b64 exec, 1
s_cbranch_scc0 L_slow_7
global_store_dword v12, v13, s[30:31]
s_branch L_sdone_8
L_slow_7:
global_store_dword v12, v13, s[30:31] sc1
L_sdone_8:
s_mov_b64 exec, -1
L_B1s:
s_waitcnt lgkmcnt(0)
s_barrier
s_lshl_b32 s52, s4, 2
s_add_u32 s52, s52, s6
s_lshl_b32 s43, s52, 2
s_add_u32 s43, s43, s3
s_lshl_b32 s43, s43, 11
s_lshl_b32 s40, s4, 7
s_add_u32 s40, s40, 524288
v_lshl_add_u32 v13, v0, 2, s40
s_lshl_b32 s40, s7, 7
s_add_u32 s40, s40, 532480
s_mov_b32 exec_lo, 0
v_mov_b32 v13, s40
s_mov_b32 exec_lo, -1
s_add_u32 s40, s43, 262144
v_lshl_add_u32 v10, v5, 8, s40
v_lshl_add_u32 v10, v4, 6, v10
v_lshl_add_u32 v10, v3, 4, v10
v_mov_b32 v52, 0
v_mov_b32 v53, 0
s_and_b32 s57, s2, 0xc1
s_cmp_eq_u32 s57, 0xc1
s_cbranch_scc1 L_noh
s_mov_b32 s44, 4194304
L_poll_9:
global_load_dword v152, v13, s[30:31] sc1
global_load_dwordx4 v[144:147], v10, s[30:31] offset:0 sc1
global_load_dwordx4 v[148:151], v10, s[30:31] offset:1024 sc1
s_waitcnt vmcnt(0)
v_xor_b32 v11, s56, v152
v_bitop3_b32 v11, v145, s56, v11 bitop3:0xbe
v_bitop3_b32 v11, v147, s56, v11 bitop3:0xbe
v_bitop3_b32 v11, v149, s56, v11 bitop3:0xbe
v_bitop3_b32 v11, v151, s56, v11 bitop3:0xbe
v_cmp_ne_u32 vcc, 0, v11
s_nop 0
s_cbranch_vccz L_pdone_10
s_mov_b64 exec, vcc
s_sub_u32 s44, s44, 1
s_cbranch_scc0 L_poll_9
L_pdone_10:
s_mov_b64 exec, -1
s_nop 0
v_add_f32_dpp v16, v144, v144 quad_perm:[1,0,3,2] row_mask:0xf bank_mask:0xf
v_add_f32_dpp v17, v146, v146 quad_perm:[1,0,3,2] row_mask:0xf bank_mask:0xf
v_add_f32_dpp v18, v148, v148 quad_perm:[1,0,3,2] row_mask:0xf bank_mask:0xf
v_add_f32_dpp v19, v150, v150 quad_perm:[1,0,3,2] row_mask:0xf bank_mask:0xf
v_cvt_pk_bf16_f32 v20, v16, v17
v_cvt_pk_bf16_f32 v21, v18, v19
v_lshlrev_b32 v16, 16, v20
v_and_b32 v17, s39, v20
v_lshlrev_b32 v18, 16, v21
v_and_b32 v19, s39, v21
v_mul_f32 v20, s53, v16
v_mul_f32 v21, s53, v17
v_mul_f32 v22, s53, v18
v_mul_f32 v23, s53, v19
v_exp_f32 v20, -v20
v_exp_f32 v21, -v21
v_exp_f32 v22, -v22
v_exp_f32 v23, -v23
v_add_f32 v20, 1.0, v20
v_add_f32 v21, 1.0, v21
v_add_f32 v22, 1.0, v22
v_add_f32 v23, 1.0, v23
v_rcp_f32 v20, v20
v_rcp_f32 v21, v21
v_rcp_f32 v22, v22
v_rcp_f32 v23, v23
v_mul_f32 v20, v16, v20
v_mul_f32 v21, v17, v21
v_mul_f32 v22, v18, v22
v_mul_f32 v23, v19, v23
v_cvt_pk_bf16_f32 v144, v20, v21
v_cvt_pk_bf16_f32 v145, v22, v23
v_lshlrev_b32 v20, 16, v144
v_and_b32 v21, s39, v144
v_lshlrev_b32 v22, 16, v145
v_and_b32 v23, s39, v145
v_mul_f32_dpp v20, v16, v20 quad_perm:[2,3,0,1] row_mask:0xf bank_mask:0xf
v_mul_f32_dpp v21, v17, v21 quad_perm:[2,3,0,1] row_mask:0xf bank_mask:0xf
v_mul_f32_dpp v22, v18, v22 quad_perm:[2,3,0,1] row_mask:0xf bank_mask:0xf
v_mul_f32_dpp v23, v19, v23 quad_perm:[2,3,0,1] row_mask:0xf bank_mask:0xf
v_cmp_eq_u32 vcc, 0, v5
v_cvt_pk_bf16_f32 v52, v20, v21
v_cvt_pk_bf16_f32 v53, v22, v23
v_cndmask_b32 v52, 0, v52, vcc
v_cndmask_b32 v53, 0, v53, vcc
s_branch L_hdone
L_noh:
s_mov_b32 s44, 4194304
L_poll_11:
global_load_dword v152, v13, s[30:31] sc1
s_waitcnt vmcnt(0)
v_cmp_ne_u32 vcc, s56, v152
s_nop 0
s_cbranch_vccz L_pdone_12
s_mov_b64 exec, vcc
s_sub_u32 s44, s44, 1
s_cbranch_scc0 L_poll_11
L_pdone_12:
s_mov_b64 exec, -1
L_hdone:
s_lshl_b32 s41, s7, 7
v_lshl_add_u32 v10, v2, 3, s41
s_lshl_b32 s42, s6, 3
s_lshr_b32 s42, s35, s42
s_and_b32 s42, s42, 31
s_lshl_b32 s42, s42, 2
s_add_u32 s42, s42, s3
s_lshl_b32 s42, s42, 14
v_lshl_add_u32 v11, v3, 12, s42
v_add_u32 v160, v11, v10
s_lshl_b32 s42, s52, 7
s_lshl_b32 s40, s3, 1
s_add_u32 s42, s42, s40
v_and_b32 v11, 1, v3
v_lshrrev_b32 v12, 1, v3
v_lshl_add_u32 v11, v11, 6, v12
v_add_u32 v11, s42, v11
v_lshl_add_u32 v161, v11, 10, v10
s_lshl_b32 s42, s52, 10
s_add_u32 s42, s42, 557056
v_lshl_add_u32 v162, v0, 4, s42
s_add_u32 s42, s43, 589824
v_lshl_add_u32 v11, v4, 9, s42
v_lshl_add_u32 v11, v5, 6, v11
v_lshl_add_u32 v163, v3, 4, v11
s_lshl_b32 s42, s7, 2
s_add_u32 s42, s42, s3
s_lshl_b32 s42, s42, 11
s_add_u32 s42, s42, 1048576
v_lshl_add_u32 v11, v3, 8, s42
v_lshl_add_u32 v164, v2, 2, v11
s_lshl_b32 s41, s3, 10
v_lshl_add_u32 v167, v0, 4, s41
s_lshl_b32 s40, s3, 8
v_lshl_add_u32 v166, v0, 2, s40
s_lshl_b32 s40, s7, 7
s_add_u32 s40, s40, s41
v_lshl_add_u32 v165, v0, 1, s40
global_load_ushort v168, v165, s[8:9]
s_mov_b32 s54, 0xaaaaaaaa
s_mov_b32 s55, 0xaaaaaaaa
v_mov_b32 v28, 0
v_mov_b32 v29, 0
v_mov_b32 v30, 0
v_mov_b32 v31, 0
v_mov_b32 v32, 0
v_mov_b32 v33, 0
v_mov_b32 v34, 0
v_mov_b32 v35, 0
s_movk_i32 s40, 8192
s_cmp_eq_u32 s57, 0xc1
s_barrier
global_load_dwordx4 v[24:27], v162, s[30:31] sc1
s_cbranch_scc1 L_nowd
global_load_dwordx2 v[28:29], v160, s[24:25] offset:0 nt
global_load_dwordx2 v[30:31], v160, s[24:25] offset:1024 nt
global_load_dwordx2 v[32:33], v160, s[24:25] offset:2048 nt
global_load_dwordx2 v[34:35], v160, s[24:25] offset:3072 nt
L_nowd:
global_load_dwordx2 v[36:37], v161, s[16:17] nt
v_add_u32 v161, s40, v161
global_load_dwordx2 v[38:39], v161, s[16:17] nt
v_add_u32 v161, s40, v161
global_load_dwordx2 v[40:41], v161, s[16:17] nt
v_add_u32 v161, s40, v161
global_load_dwordx2 v[42:43], v161, s[16:17] nt
v_add_u32 v161, s40, v161
global_load_dwordx2 v[44:45], v161, s[16:17] nt
v_add_u32 v161, s40, v161
global_load_dwordx2 v[46:47], v161, s[16:17] nt
v_add_u32 v161, s40, v161
global_load_dwordx2 v[48:49], v161, s[16:17] nt
v_add_u32 v161, s40, v161
global_load_dwordx2 v[50:51], v161, s[16:17] nt
s_barrier
s_waitcnt vmcnt(8)
s_mov_b32 s44, 4194304
s_branch L_pchk_15
L_poll_13:
global_load_dwordx4 v[24:27], v162, s[30:31] sc1
s_waitcnt vmcnt(0)
L_pchk_15:
v_max3_u32 v11, v24, v25, v26
v_max_u32 v11, v11, v27
v_cmp_eq_u32 vcc, -1, v11
s_nop 0
s_cbranch_vccz L_pdone_14
s_mov_b64 exec, vcc
s_sub_u32 s44, s44, 1
s_cbranch_scc0 L_poll_13
L_pdone_14:
s_mov_b64 exec, -1
v_max_f32 v10, v24, v26
v_perm_b32 v64, v30, v28, s37
v_perm_b32 v65, v34, v32, s37
v_max_f32_dpp v10, v10, v10 quad_perm:[1,0,3,2] row_mask:0xf bank_mask:0xf
v_perm_b32 v66, v30, v28, s38
v_perm_b32 v67, v34, v32, s38
v_max_f32_dpp v11, v10, v10 quad_perm:[2,3,0,1] row_mask:0xf bank_mask:0xf
v_perm_b32 v68, v31, v29, s37
v_perm_b32 v69, v35, v33, s37
v_max_f32_dpp v11, v11, v11 row_ror:4 row_mask:0xf bank_mask:0xf
v_perm_b32 v70, v31, v29, s38
v_perm_b32 v71, v35, v33, s38
v_max_f32_dpp v11, v11, v11 row_ror:8 row_mask:0xf bank_mask:0xf
v_sub_f32 v24, v24, v11
v_sub_f32 v26, v26, v11
v_sub_f32 v10, v10, v11
v_mul_f32 v24, s53, v24
v_mul_f32 v26, s53, v26
v_mul_f32 v10, s53, v10
v_exp_f32 v24, v24
v_exp_f32 v26, v26
v_exp_f32 v10, v10
v_mul_f32 v12, v24, v25
v_fmac_f32 v12, v26, v27
v_mfma_f32_16x16x16_bf16 v[88:91], v[52:53], v[64:65], 0
s_nop 0
v_add_f32_dpp v12, v12, v12 quad_perm:[1,0,3,2] row_mask:0xf bank_mask:0xf
v_mfma_f32_16x16x16_bf16 v[92:95], v[52:53], v[66:67], 0
s_nop 0
v_add_f32_dpp v12, v12, v12 quad_perm:[2,3,0,1] row_mask:0xf bank_mask:0xf
v_mfma_f32_16x16x16_bf16 v[96:99], v[52:53], v[68:69], 0
s_nop 0
v_add_f32_dpp v12, v12, v12 row_ror:8 row_mask:0xf bank_mask:0xf
v_mfma_f32_16x16x16_bf16 v[100:103], v[52:53], v[70:71], 0
s_nop 0
v_add_f32_dpp v12, v12, v12 row_ror:4 row_mask:0xf bank_mask:0xf
v_rcp_f32 v12, v12
s_nop 0
v_mul_f32 v10, v10, v12
s_nop 1
v_mov_b32_dpp v56, v10 row_newbcast:0 row_mask:0xf bank_mask:0xf
v_mov_b32_dpp v57, v10 row_newbcast:2 row_mask:0xf bank_mask:0xf
v_mov_b32_dpp v58, v10 row_newbcast:4 row_mask:0xf bank_mask:0xf
v_mov_b32_dpp v59, v10 row_newbcast:6 row_mask:0xf bank_mask:0xf
v_mov_b32_dpp v60, v10 row_newbcast:8 row_mask:0xf bank_mask:0xf
v_mov_b32_dpp v61, v10 row_newbcast:10 row_mask:0xf bank_mask:0xf
v_mov_b32_dpp v62, v10 row_newbcast:12 row_mask:0xf bank_mask:0xf
v_mov_b32_dpp v63, v10 row_newbcast:14 row_mask:0xf bank_mask:0xf
s_waitcnt vmcnt(6)
v_perm_b32 v72, v38, v36, s37
v_perm_b32 v76, v38, v36, s38
v_perm_b32 v80, v39, v37, s37
v_perm_b32 v84, v39, v37, s38
s_waitcnt vmcnt(4)
global_load_dwordx4 v[104:107], v163, s[30:31] offset:0 sc1
global_load_dwordx4 v[108:111], v163, s[30:31] offset:256 sc1
v_perm_b32 v73, v42, v40, s37
v_perm_b32 v77, v42, v40, s38
v_perm_b32 v81, v43, v41, s37
v_perm_b32 v85, v43, v41, s38
s_waitcnt vmcnt(4)
v_perm_b32 v74, v46, v44, s37
v_perm_b32 v78, v46, v44, s38
v_perm_b32 v82, v47, v45, s37
v_perm_b32 v86, v47, v45, s38
s_waitcnt vmcnt(2)
v_perm_b32 v75, v50, v48, s37
v_perm_b32 v79, v50, v48, s38
v_perm_b32 v83, v51, v49, s37
v_perm_b32 v87, v51, v49, s38
s_waitcnt vmcnt(0)
s_mov_b32 s44, 4194304
s_branch L_pchk_18
L_poll_16:
global_load_dwordx4 v[104:107], v163, s[30:31] offset:0 sc1
global_load_dwordx4 v[108:111], v163, s[30:31] offset:256 sc1
s_waitcnt vmcnt(0)
L_pchk_18:
v_max3_u32 v11, v104, v105, v106
v_max3_u32 v11, v11, v107, v108
v_max3_u32 v11, v11, v109, v110
v_max_u32 v11, v11, v111
v_cmp_eq_u32 vcc, -1, v11
s_nop 0
s_cbranch_vccz L_pdone_17
s_mov_b64 exec, vcc
s_sub_u32 s44, s44, 1
s_cbranch_scc0 L_poll_16
L_pdone_17:
s_mov_b64 exec, -1
v_mfma_f32_16x16x32_bf16 v[112:115], v[104:107], v[72:75], 0
v_mfma_f32_16x16x32_bf16 v[116:119], v[104:107], v[76:79], 0
v_mfma_f32_16x16x32_bf16 v[120:123], v[104:107], v[80:83], 0
v_mfma_f32_16x16x32_bf16 v[124:127], v[104:107], v[84:87], 0
v_mfma_f32_16x16x32_bf16 v[128:131], v[108:111], v[72:75], 0
s_nop 3
v_pk_fma_f32 v[88:89], v[112:113], v[56:57], v[88:89]
v_pk_fma_f32 v[88:89], v[114:115], v[58:59], v[88:89]
v_mfma_f32_16x16x32_bf16 v[132:135], v[108:111], v[76:79], 0
v_pk_fma_f32 v[92:93], v[116:117], v[56:57], v[92:93]
v_pk_fma_f32 v[92:93], v[118:119], v[58:59], v[92:93]
v_mfma_f32_16x16x32_bf16 v[136:139], v[108:111], v[80:83], 0
v_pk_fma_f32 v[96:97], v[120:121], v[56:57], v[96:97]
v_pk_fma_f32 v[96:97], v[122:123], v[58:59], v[96:97]
v_mfma_f32_16x16x32_bf16 v[140:143], v[108:111], v[84:87], 0
v_pk_fma_f32 v[100:101], v[124:125], v[56:57], v[100:101]
v_pk_fma_f32 v[100:101], v[126:127], v[58:59], v[100:101]
v_pk_fma_f32 v[88:89], v[128:129], v[60:61], v[88:89]
v_pk_fma_f32 v[88:89], v[130:131], v[62:63], v[88:89]
v_pk_fma_f32 v[92:93], v[132:133], v[60:61], v[92:93]
v_pk_fma_f32 v[92:93], v[134:135], v[62:63], v[92:93]
v_add_f32 v24, v88, v89
v_pk_fma_f32 v[96:97], v[136:137], v[60:61], v[96:97]
v_pk_fma_f32 v[96:97], v[138:139], v[62:63], v[96:97]
v_add_f32 v25, v92, v93
v_pk_fma_f32 v[100:101], v[140:141], v[60:61], v[100:101]
v_pk_fma_f32 v[100:101], v[142:143], v[62:63], v[100:101]
v_add_f32 v26, v96, v97
v_add_f32 v27, v100, v101
ds_write_b128 v167, v[24:27] offset:0
s_waitcnt lgkmcnt(0)
s_barrier
ds_read2st64_b32 v[112:113], v166 offset0:0 offset1:4
ds_read2st64_b32 v[114:115], v166 offset0:8 offset1:12
v_lshlrev_b32 v168, 16, v168
s_waitcnt lgkmcnt(0)
v_pk_add_f32 v[112:113], v[112:113], v[114:115]
v_add_f32 v112, v112, v113
v_cndmask_b32 v24, v112, 1.0, s[54:55]
v_cndmask_b32 v25, 1.0, v112, s[54:55]
global_atomic_add_f32 v26, v164, v24, s[30:31] sc0 sc1
global_atomic_add_f32 v27, v164, v25, s[30:31] offset:1024 sc0 sc1
v_add_f32 v168, v168, v112
s_mov_b32 s40, 0x41f80000
s_waitcnt vmcnt(1)
v_cmp_eq_f32 vcc, s40, v26
s_and_b64 vcc, vcc, s[54:55]
s_lshr_b64 s[58:59], vcc, 1
s_waitcnt vmcnt(0)
v_cmp_eq_f32 vcc, s40, v27
v_cndmask_b32 v26, v26, v27, s[54:55]
s_andn2_b64 vcc, vcc, s[54:55]
v_add_f32 v168, v168, v26
s_lshl_b64 vcc, vcc, 1
v_cvt_pk_bf16_f32 v168, v168, v168
s_or_b64 exec, vcc, s[58:59]
s_cbranch_execz L_svcend
global_store_short v165, v168, s[26:27]
s_or_b32 s40, s7, s3
s_cbranch_scc1 L_svcend
s_bitcmp1_b32 s58, 0
s_cbranch_scc0 L_svcend
s_mov_b64 exec, 0xffffffff
s_mov_b32 s40, 528384
v_lshl_add_u32 v10, v0, 2, s40
v_mov_b32 v11, s56
global_store_dword v10, v11, s[30:31]
L_svcend:
s_endpgm
L_stream:
s_sub_u32 s3, s3, 4
s_lshl_b32 s40, s6, 3
s_add_u32 s40, s40, s4
s_lshl_b32 s40, s40, 22
s_lshl_b32 s41, s7, 17
s_add_u32 s40, s40, s41
s_add_u32 s40, s40, 3145728
s_lshl_b32 s41, s3, 10
s_lshl_b32 s42, s5, 12
s_add_u32 s41, s41, s42
v_lshl_add_u32 v6, v0, 4, s41
v_lshl_add_u32 v7, v5, 4, s41
v_lshl_add_u32 v7, v4, 8, v7
v_lshl_add_u32 v7, v3, 6, v7
s_waitcnt lgkmcnt(0)
s_add_u32 s10, s10, s40
s_addc_u32 s11, s11, 0
s_add_u32 s12, s12, s40
s_addc_u32 s13, s13, 0
global_load_dwordx4 v[16:19], v7, s[10:11] nt
v_xor_b32 v9, 0x1000, v7
global_load_dwordx4 v[20:23], v9, s[10:11] nt
v_xor_b32 v8, 0x2000, v7
global_load_dwordx4 v[24:27], v8, s[10:11] nt
s_barrier
v_xor_b32 v9, 0x3000, v7
global_load_dwordx4 v[28:31], v9, s[10:11] nt
v_xor_b32 v8, 0x4000, v7
global_load_dwordx4 v[32:35], v8, s[10:11] nt
v_xor_b32 v9, 0x5000, v7
global_load_dwordx4 v[36:39], v9, s[10:11] nt
v_xor_b32 v8, 0x6000, v7
global_load_dwordx4 v[40:43], v8, s[10:11] nt
v_xor_b32 v9, 0x7000, v7
global_load_dwordx4 v[44:47], v9, s[10:11] nt
v_xor_b32 v8, 0x8000, v7
global_load_dwordx4 v[48:51], v8, s[10:11] nt
v_xor_b32 v9, 0x9000, v7
global_load_dwordx4 v[52:55], v9, s[10:11] nt
v_xor_b32 v8, 0xa000, v7
global_load_dwordx4 v[56:59], v8, s[10:11] nt
v_xor_b32 v9, 0xb000, v7
global_load_dwordx4 v[60:63], v9, s[10:11] nt
v_xor_b32 v8, 0xc000, v7
global_load_dwordx4 v[64:67], v8, s[10:11] nt
v_xor_b32 v9, 0xd000, v7
global_load_dwordx4 v[68:71], v9, s[10:11] nt
v_xor_b32 v8, 0xe000, v7
global_load_dwordx4 v[72:75], v8, s[10:11] nt
v_xor_b32 v9, 0xf000, v7
global_load_dwordx4 v[76:79], v9, s[10:11] nt
v_xor_b32 v8, 0x10000, v7
global_load_dwordx4 v[80:83], v8, s[10:11] nt
v_xor_b32 v9, 0x11000, v7
global_load_dwordx4 v[84:87], v9, s[10:11] nt
v_xor_b32 v8, 0x12000, v7
global_load_dwordx4 v[88:91], v8, s[10:11] nt
v_xor_b32 v9, 0x13000, v7
global_load_dwordx4 v[92:95], v9, s[10:11] nt
v_xor_b32 v8, 0x14000, v7
global_load_dwordx4 v[96:99], v8, s[10:11] nt
v_xor_b32 v9, 0x15000, v7
global_load_dwordx4 v[100:103], v9, s[10:11] nt
v_xor_b32 v8, 0x16000, v7
global_load_dwordx4 v[104:107], v8, s[10:11] nt
v_xor_b32 v9, 0x17000, v7
global_load_dwordx4 v[108:111], v9, s[10:11] nt
v_xor_b32 v8, 0x18000, v7
global_load_dwordx4 v[112:115], v8, s[10:11] nt
v_xor_b32 v9, 0x19000, v7
global_load_dwordx4 v[116:119], v9, s[10:11] nt
v_xor_b32 v8, 0x1a000, v7
global_load_dwordx4 v[120:123], v8, s[10:11] nt
v_xor_b32 v9, 0x1b000, v7
global_load_dwordx4 v[124:127], v9, s[10:11] nt
v_xor_b32 v8, 0x1c000, v7
global_load_dwordx4 v[128:131], v8, s[10:11] nt
v_xor_b32 v9, 0x1d000, v7
global_load_dwordx4 v[132:135], v9, s[10:11] nt
v_xor_b32 v8, 0x1e000, v7
global_load_dwordx4 v[136:139], v8, s[10:11] nt
v_xor_b32 v9, 0x1f000, v7
global_load_dwordx4 v[140:143], v9, s[10:11] nt
global_load_dwordx4 v[144:147], v6, s[12:13] nt
v_xor_b32 v9, 0x1000, v6
global_load_dwordx4 v[148:151], v9, s[12:13] nt
v_xor_b32 v8, 0x2000, v6
global_load_dwordx4 v[152:155], v8, s[12:13] nt
v_xor_b32 v9, 0x3000, v6
global_load_dwordx4 v[156:159], v9, s[12:13] nt
v_xor_b32 v8, 0x4000, v6
global_load_dwordx4 v[160:163], v8, s[12:13] nt
v_xor_b32 v9, 0x5000, v6
global_load_dwordx4 v[164:167], v9, s[12:13] nt
v_xor_b32 v8, 0x6000, v6
global_load_dwordx4 v[168:171], v8, s[12:13] nt
v_xor_b32 v9, 0x7000, v6
global_load_dwordx4 v[172:175], v9, s[12:13] nt
v_xor_b32 v8, 0x8000, v6
global_load_dwordx4 v[176:179], v8, s[12:13] nt
v_xor_b32 v9, 0x9000, v6
global_load_dwordx4 v[180:183], v9, s[12:13] nt
v_xor_b32 v8, 0xa000, v6
global_load_dwordx4 v[184:187], v8, s[12:13] nt
v_xor_b32 v9, 0xb000, v6
global_load_dwordx4 v[188:191], v9, s[12:13] nt
s_mov_b32 s39, 0xffff0000
s_mov_b32 s37, 0x05040100
s_mov_b32 s38, 0x07060302
s_mov_b32 s53, 0x3fb8aa3b
v_lshlrev_b32 v10, 8, v5
v_lshl_add_u32 v10, v3, 6, v10
v_lshl_add_u32 v10, v4, 4, v10
v_mov_b32 v11, 13376
s_barrier
ds_read_b128 v[200:203], v10 offset:12288
ds_read_b32 v11, v11
s_waitcnt lgkmcnt(0)
v_readfirstlane_b32 s45, v11
s_waitcnt vmcnt(43)
v_mfma_f32_16x16x32_bf16 v[204:207], v[16:19], v[200:203], 0
s_waitcnt vmcnt(42)
v_mfma_f32_16x16x32_bf16 v[208:211], v[20:23], v[200:203], 0
s_waitcnt vmcnt(41)
v_mfma_f32_16x16x32_bf16 v[212:215], v[24:27], v[200:203], 0
s_waitcnt vmcnt(40)
v_mfma_f32_16x16x32_bf16 v[216:219], v[28:31], v[200:203], 0
s_nop 1
v_add_f32_dpp v192, v205, v204 row_ror:12 row_mask:0xf bank_mask:0x1
s_nop 0
v_add_f32_dpp v193, v209, v208 row_ror:12 row_mask:0xf bank_mask:0x1
s_waitcnt vmcnt(39)
v_mfma_f32_16x16x32_bf16 v[220:223], v[32:35], v[200:203], 0
v_add_f32_dpp v192, v206, v192 row_ror:8 row_mask:0xf bank_mask:0x1
v_add_f32_dpp v193, v210, v193 row_ror:8 row_mask:0xf bank_mask:0x1
s_waitcnt vmcnt(38)
v_mfma_f32_16x16x32_bf16 v[224:227], v[36:39], v[200:203], 0
v_add_f32_dpp v192, v207, v192 row_ror:4 row_mask:0xf bank_mask:0x1
v_add_f32_dpp v193, v211, v193 row_ror:4 row_mask:0xf bank_mask:0x1
s_nop 0
v_add_f32_dpp v192, v212, v213 row_ror:4 row_mask:0xf bank_mask:0x2
v_add_f32_dpp v193, v216, v217 row_ror:4 row_mask:0xf bank_mask:0x2
s_waitcnt vmcnt(37)
v_mfma_f32_16x16x32_bf16 v[228:231], v[40:43], v[200:203], 0
v_add_f32_dpp v192, v214, v192 row_ror:12 row_mask:0xf bank_mask:0x2
v_add_f32_dpp v193, v218, v193 row_ror:12 row_mask:0xf bank_mask:0x2
s_waitcnt vmcnt(36)
v_mfma_f32_16x16x32_bf16 v[232:235], v[44:47], v[200:203], 0
v_add_f32_dpp v192, v215, v192 row_ror:8 row_mask:0xf bank_mask:0x2
v_add_f32_dpp v193, v219, v193 row_ror:8 row_mask:0xf bank_mask:0x2
s_nop 0
v_add_f32_dpp v192, v220, v222 row_ror:8 row_mask:0xf bank_mask:0x4
v_add_f32_dpp v193, v224, v226 row_ror:8 row_mask:0xf bank_mask:0x4
s_waitcnt vmcnt(35)
v_mfma_f32_16x16x32_bf16 v[204:207], v[48:51], v[200:203], 0
v_add_f32_dpp v192, v221, v192 row_ror:4 row_mask:0xf bank_mask:0x4
v_add_f32_dpp v193, v225, v193 row_ror:4 row_mask:0xf bank_mask:0x4
s_waitcnt vmcnt(34)
v_mfma_f32_16x16x32_bf16 v[208:211], v[52:55], v[200:203], 0
v_add_f32_dpp v192, v223, v192 row_ror:12 row_mask:0xf bank_mask:0x4
v_add_f32_dpp v193, v227, v193 row_ror:12 row_mask:0xf bank_mask:0x4
s_nop 0
v_add_f32_dpp v192, v228, v231 row_ror:12 row_mask:0xf bank_mask:0x8
v_add_f32_dpp v193, v232, v235 row_ror:12 row_mask:0xf bank_mask:0x8
s_waitcnt vmcnt(33)
v_mfma_f32_16x16x32_bf16 v[212:215], v[56:59], v[200:203], 0
v_add_f32_dpp v192, v229, v192 row_ror:8 row_mask:0xf bank_mask:0x8
v_add_f32_dpp v193, v233, v193 row_ror:8 row_mask:0xf bank_mask:0x8
s_waitcnt vmcnt(32)
v_mfma_f32_16x16x32_bf16 v[216:219], v[60:63], v[200:203], 0
v_add_f32_dpp v192, v230, v192 row_ror:4 row_mask:0xf bank_mask:0x8
v_add_f32_dpp v193, v234, v193 row_ror:4 row_mask:0xf bank_mask:0x8
v_add_f32_dpp v194, v205, v204 row_ror:12 row_mask:0xf bank_mask:0x1
v_add_f32_dpp v195, v209, v208 row_ror:12 row_mask:0xf bank_mask:0x1
s_waitcnt vmcnt(31)
v_mfma_f32_16x16x32_bf16 v[220:223], v[64:67], v[200:203], 0
v_add_f32_dpp v194, v206, v194 row_ror:8 row_mask:0xf bank_mask:0x1
v_add_f32_dpp v195, v210, v195 row_ror:8 row_mask:0xf bank_mask:0x1
s_waitcnt vmcnt(30)
v_mfma_f32_16x16x32_bf16 v[224:227], v[68:71], v[200:203], 0
v_add_f32_dpp v194, v207, v194 row_ror:4 row_mask:0xf bank_mask:0x1
v_add_f32_dpp v195, v211, v195 row_ror:4 row_mask:0xf bank_mask:0x1
s_nop 0
v_add_f32_dpp v194, v212, v213 row_ror:4 row_mask:0xf bank_mask:0x2
v_add_f32_dpp v195, v216, v217 row_ror:4 row_mask:0xf bank_mask:0x2
s_waitcnt vmcnt(29)
v_mfma_f32_16x16x32_bf16 v[228:231], v[72:75], v[200:203], 0
v_add_f32_dpp v194, v214, v194 row_ror:12 row_mask:0xf bank_mask:0x2
v_add_f32_dpp v195, v218, v195 row_ror:12 row_mask:0xf bank_mask:0x2
s_waitcnt vmcnt(28)
v_mfma_f32_16x16x32_bf16 v[232:235], v[76:79], v[200:203], 0
v_add_f32_dpp v194, v215, v194 row_ror:8 row_mask:0xf bank_mask:0x2
v_add_f32_dpp v195, v219, v195 row_ror:8 row_mask:0xf bank_mask:0x2
s_nop 0
v_add_f32_dpp v194, v220, v222 row_ror:8 row_mask:0xf bank_mask:0x4
v_add_f32_dpp v195, v224, v226 row_ror:8 row_mask:0xf bank_mask:0x4
s_waitcnt vmcnt(27)
v_mfma_f32_16x16x32_bf16 v[204:207], v[80:83], v[200:203], 0
v_add_f32_dpp v194, v221, v194 row_ror:4 row_mask:0xf bank_mask:0x4
v_add_f32_dpp v195, v225, v195 row_ror:4 row_mask:0xf bank_mask:0x4
s_waitcnt vmcnt(26)
v_mfma_f32_16x16x32_bf16 v[208:211], v[84:87], v[200:203], 0
v_add_f32_dpp v194, v223, v194 row_ror:12 row_mask:0xf bank_mask:0x4
v_add_f32_dpp v195, v227, v195 row_ror:12 row_mask:0xf bank_mask:0x4
s_nop 0
v_add_f32_dpp v194, v228, v231 row_ror:12 row_mask:0xf bank_mask:0x8
v_add_f32_dpp v195, v232, v235 row_ror:12 row_mask:0xf bank_mask:0x8
s_waitcnt vmcnt(25)
v_mfma_f32_16x16x32_bf16 v[212:215], v[88:91], v[200:203], 0
v_add_f32_dpp v194, v229, v194 row_ror:8 row_mask:0xf bank_mask:0x8
v_add_f32_dpp v195, v233, v195 row_ror:8 row_mask:0xf bank_mask:0x8
s_waitcnt vmcnt(24)
v_mfma_f32_16x16x32_bf16 v[216:219], v[92:95], v[200:203], 0
v_add_f32_dpp v194, v230, v194 row_ror:4 row_mask:0xf bank_mask:0x8
v_add_f32_dpp v195, v234, v195 row_ror:4 row_mask:0xf bank_mask:0x8
v_add_f32_dpp v196, v205, v204 row_ror:12 row_mask:0xf bank_mask:0x1
v_add_f32_dpp v197, v209, v208 row_ror:12 row_mask:0xf bank_mask:0x1
s_waitcnt vmcnt(23)
v_mfma_f32_16x16x32_bf16 v[220:223], v[96:99], v[200:203], 0
v_add_f32_dpp v196, v206, v196 row_ror:8 row_mask:0xf bank_mask:0x1
v_add_f32_dpp v197, v210, v197 row_ror:8 row_mask:0xf bank_mask:0x1
s_waitcnt vmcnt(22)
v_mfma_f32_16x16x32_bf16 v[224:227], v[100:103], v[200:203], 0
v_add_f32_dpp v196, v207, v196 row_ror:4 row_mask:0xf bank_mask:0x1
v_add_f32_dpp v197, v211, v197 row_ror:4 row_mask:0xf bank_mask:0x1
s_nop 0
v_add_f32_dpp v196, v212, v213 row_ror:4 row_mask:0xf bank_mask:0x2
v_add_f32_dpp v197, v216, v217 row_ror:4 row_mask:0xf bank_mask:0x2
s_waitcnt vmcnt(21)
v_mfma_f32_16x16x32_bf16 v[228:231], v[104:107], v[200:203], 0
v_add_f32_dpp v196, v214, v196 row_ror:12 row_mask:0xf bank_mask:0x2
v_add_f32_dpp v197, v218, v197 row_ror:12 row_mask:0xf bank_mask:0x2
s_waitcnt vmcnt(20)
v_mfma_f32_16x16x32_bf16 v[232:235], v[108:111], v[200:203], 0
v_add_f32_dpp v196, v215, v196 row_ror:8 row_mask:0xf bank_mask:0x2
v_add_f32_dpp v197, v219, v197 row_ror:8 row_mask:0xf bank_mask:0x2
s_nop 0
v_add_f32_dpp v196, v220, v222 row_ror:8 row_mask:0xf bank_mask:0x4
v_add_f32_dpp v197, v224, v226 row_ror:8 row_mask:0xf bank_mask:0x4
s_waitcnt vmcnt(19)
v_mfma_f32_16x16x32_bf16 v[204:207], v[112:115], v[200:203], 0
v_add_f32_dpp v196, v221, v196 row_ror:4 row_mask:0xf bank_mask:0x4
v_add_f32_dpp v197, v225, v197 row_ror:4 row_mask:0xf bank_mask:0x4
s_waitcnt vmcnt(18)
v_mfma_f32_16x16x32_bf16 v[208:211], v[116:119], v[200:203], 0
v_add_f32_dpp v196, v223, v196 row_ror:12 row_mask:0xf bank_mask:0x4
v_add_f32_dpp v197, v227, v197 row_ror:12 row_mask:0xf bank_mask:0x4
s_nop 0
v_add_f32_dpp v196, v228, v231 row_ror:12 row_mask:0xf bank_mask:0x8
v_add_f32_dpp v197, v232, v235 row_ror:12 row_mask:0xf bank_mask:0x8
s_waitcnt vmcnt(17)
v_mfma_f32_16x16x32_bf16 v[212:215], v[120:123], v[200:203], 0
v_add_f32_dpp v196, v229, v196 row_ror:8 row_mask:0xf bank_mask:0x8
v_add_f32_dpp v197, v233, v197 row_ror:8 row_mask:0xf bank_mask:0x8
s_waitcnt vmcnt(16)
v_mfma_f32_16x16x32_bf16 v[216:219], v[124:127], v[200:203], 0
v_add_f32_dpp v196, v230, v196 row_ror:4 row_mask:0xf bank_mask:0x8
v_add_f32_dpp v197, v234, v197 row_ror:4 row_mask:0xf bank_mask:0x8
v_add_f32_dpp v198, v205, v204 row_ror:12 row_mask:0xf bank_mask:0x1
v_add_f32_dpp v199, v209, v208 row_ror:12 row_mask:0xf bank_mask:0x1
s_waitcnt vmcnt(15)
v_mfma_f32_16x16x32_bf16 v[220:223], v[128:131], v[200:203], 0
v_add_f32_dpp v198, v206, v198 row_ror:8 row_mask:0xf bank_mask:0x1
v_add_f32_dpp v199, v210, v199 row_ror:8 row_mask:0xf bank_mask:0x1
s_waitcnt vmcnt(14)
v_mfma_f32_16x16x32_bf16 v[224:227], v[132:135], v[200:203], 0
v_add_f32_dpp v198, v207, v198 row_ror:4 row_mask:0xf bank_mask:0x1
v_add_f32_dpp v199, v211, v199 row_ror:4 row_mask:0xf bank_mask:0x1
s_nop 0
v_add_f32_dpp v198, v212, v213 row_ror:4 row_mask:0xf bank_mask:0x2
v_add_f32_dpp v199, v216, v217 row_ror:4 row_mask:0xf bank_mask:0x2
s_waitcnt vmcnt(13)
v_mfma_f32_16x16x32_bf16 v[228:231], v[136:139], v[200:203], 0
v_add_f32_dpp v198, v214, v198 row_ror:12 row_mask:0xf bank_mask:0x2
v_add_f32_dpp v199, v218, v199 row_ror:12 row_mask:0xf bank_mask:0x2
s_waitcnt vmcnt(12)
v_mfma_f32_16x16x32_bf16 v[232:235], v[140:143], v[200:203], 0
v_add_f32_dpp v198, v215, v198 row_ror:8 row_mask:0xf bank_mask:0x2
v_add_f32_dpp v199, v219, v199 row_ror:8 row_mask:0xf bank_mask:0x2
s_nop 0
v_add_f32_dpp v198, v220, v222 row_ror:8 row_mask:0xf bank_mask:0x4
v_add_f32_dpp v199, v224, v226 row_ror:8 row_mask:0xf bank_mask:0x4
s_nop 0
v_add_f32_dpp v198, v221, v198 row_ror:4 row_mask:0xf bank_mask:0x4
v_add_f32_dpp v199, v225, v199 row_ror:4 row_mask:0xf bank_mask:0x4
s_nop 0
v_add_f32_dpp v198, v223, v198 row_ror:12 row_mask:0xf bank_mask:0x4
v_add_f32_dpp v199, v227, v199 row_ror:12 row_mask:0xf bank_mask:0x4
s_nop 0
v_add_f32_dpp v198, v228, v231 row_ror:12 row_mask:0xf bank_mask:0x8
v_add_f32_dpp v199, v232, v235 row_ror:12 row_mask:0xf bank_mask:0x8
s_nop 0
v_add_f32_dpp v198, v229, v198 row_ror:8 row_mask:0xf bank_mask:0x8
v_add_f32_dpp v199, v233, v199 row_ror:8 row_mask:0xf bank_mask:0x8
s_nop 0
v_add_f32_dpp v198, v230, v198 row_ror:4 row_mask:0xf bank_mask:0x8
v_add_f32_dpp v199, v234, v199 row_ror:4 row_mask:0xf bank_mask:0x8
v_xor_b32 v8, 0xc000, v6
global_load_dwordx4 v[16:19], v8, s[12:13] nt
v_xor_b32 v9, 0xd000, v6
global_load_dwordx4 v[20:23], v9, s[12:13] nt
s_mov_b32 s46, 0x3db504f3
s_mov_b32 s47, 0x3db504f3
v_cvt_pk_bf16_f32 v244, v192, v193
v_cvt_pk_bf16_f32 v245, v194, v195
v_cvt_pk_bf16_f32 v246, v196, v197
v_cvt_pk_bf16_f32 v247, v198, v199
v_lshlrev_b32 v192, 16, v244
v_and_b32 v193, s39, v244
v_lshlrev_b32 v194, 16, v245
v_and_b32 v195, s39, v245
v_lshlrev_b32 v196, 16, v246
v_and_b32 v197, s39, v246
v_lshlrev_b32 v198, 16, v247
v_and_b32 v199, s39, v247
v_pk_mul_f32 v[192:193], v[192:193], s[46:47]
v_pk_mul_f32 v[194:195], v[194:195], s[46:47]
v_pk_mul_f32 v[196:197], v[196:197], s[46:47]
v_pk_mul_f32 v[198:199], v[198:199], s[46:47]
v_cvt_pk_bf16_f32 v244, v192, v193
v_cvt_pk_bf16_f32 v245, v194, v195
v_cvt_pk_bf16_f32 v246, v196, v197
v_cvt_pk_bf16_f32 v247, v198, v199
v_lshlrev_b32 v192, 16, v244
v_and_b32 v193, s39, v244
v_lshlrev_b32 v194, 16, v245
v_and_b32 v195, s39, v245
v_lshlrev_b32 v196, 16, v246
v_and_b32 v197, s39, v246
v_lshlrev_b32 v198, 16, v247
v_and_b32 v199, s39, v247
v_max3_f32 v248, v192, v193, v194
v_max3_f32 v250, v195, v196, v197
v_max3_f32 v248, v248, v198, v199
v_max_f32 v248, v248, v250
s_nop 1
v_max_f32_dpp v248, v248, v248 row_ror:4 row_mask:0xf bank_mask:0xf
s_nop 1
v_max_f32_dpp v248, v248, v248 row_ror:8 row_mask:0xf bank_mask:0xf
v_mov_b32 v250, v248
s_nop 1
v_permlane16_swap_b32 v248, v250
v_max_f32 v248, v248, v250
v_mov_b32 v250, v248
s_nop 1
v_permlane32_swap_b32 v248, v250
v_max_f32 v248, v248, v250
s_mov_b32 s46, 0x3fb8aa3b
s_mov_b32 s47, 0x3fb8aa3b
v_pk_add_f32 v[192:193], v[192:193], v[248:249] op_sel_hi:[1,0] neg_lo:[0,1] neg_hi:[0,1]
v_pk_add_f32 v[194:195], v[194:195], v[248:249] op_sel_hi:[1,0] neg_lo:[0,1] neg_hi:[0,1]
v_pk_add_f32 v[196:197], v[196:197], v[248:249] op_sel_hi:[1,0] neg_lo:[0,1] neg_hi:[0,1]
v_pk_add_f32 v[198:199], v[198:199], v[248:249] op_sel_hi:[1,0] neg_lo:[0,1] neg_hi:[0,1]
v_pk_mul_f32 v[192:193], v[192:193], s[46:47]
v_pk_mul_f32 v[194:195], v[194:195], s[46:47]
v_pk_mul_f32 v[196:197], v[196:197], s[46:47]
v_pk_mul_f32 v[198:199], v[198:199], s[46:47]
v_exp_f32 v192, v192
v_exp_f32 v193, v193
v_exp_f32 v194, v194
v_exp_f32 v195, v195
v_exp_f32 v196, v196
v_exp_f32 v197, v197
v_exp_f32 v198, v198
v_exp_f32 v199, v199
v_cvt_pk_bf16_f32 v244, v192, v193
v_cvt_pk_bf16_f32 v245, v194, v195
v_cvt_pk_bf16_f32 v246, v196, v197
v_cvt_pk_bf16_f32 v247, v198, v199
v_pk_add_f32 v[192:193], v[192:193], v[194:195]
v_pk_add_f32 v[196:197], v[196:197], v[198:199]
v_pk_add_f32 v[192:193], v[192:193], v[196:197]
v_add_f32 v249, v192, v193
s_nop 1
v_add_f32_dpp v249, v249, v249 row_ror:4 row_mask:0xf bank_mask:0xf
s_nop 1
v_add_f32_dpp v249, v249, v249 row_ror:8 row_mask:0xf bank_mask:0xf
v_mov_b32 v250, v249
s_nop 1
v_permlane16_swap_b32 v249, v250
v_add_f32 v249, v249, v250
v_mov_b32 v250, v249
s_nop 1
v_permlane32_swap_b32 v249, v250
v_add_f32 v249, v249, v250
s_lshl_b32 s40, s4, 12
s_lshl_b32 s41, s5, 5
s_add_u32 s40, s40, s41
s_lshl_b32 s41, s3, 3
s_add_u32 s40, s40, s41
s_add_u32 s40, s40, 557056
v_lshl_add_u32 v10, v5, 10, s40
s_lshl_b32 s41, s3, 2
v_lshl_add_u32 v11, v5, 4, s41
v_min_u32 v248, -2, v248
v_min_u32 v249, -2, v249
s_cmp_eq_u32 s45, 0
s_mov_b64 exec, 0xf
s_cbranch_scc0 L_slow_19
global_store_dwordx2 v10, v[248:249], s[30:31]
s_branch L_sdone_20
L_slow_19:
global_store_dwordx2 v10, v[248:249], s[30:31] sc1
L_sdone_20:
ds_write_b32 v11, v248 offset:13312
s_mov_b64 exec, -1
v_xor_b32 v8, 0xe000, v6
global_load_dwordx4 v[24:27], v8, s[12:13] nt
v_xor_b32 v9, 0xf000, v6
global_load_dwordx4 v[28:31], v9, s[12:13] nt
v_mov_b32 v96, 0
v_mov_b32 v97, 0
v_mov_b32 v98, 0
v_mov_b32 v99, 0
v_mov_b32 v100, 0
v_mov_b32 v101, 0
v_mov_b32 v102, 0
v_mov_b32 v103, 0
v_mov_b32 v104, 0
v_mov_b32 v105, 0
v_mov_b32 v106, 0
v_mov_b32 v107, 0
v_mov_b32 v108, 0
v_mov_b32 v109, 0
v_mov_b32 v110, 0
v_mov_b32 v111, 0
v_mov_b32 v112, 0
v_mov_b32 v113, 0
v_mov_b32 v114, 0
v_mov_b32 v115, 0
v_mov_b32 v116, 0
v_mov_b32 v117, 0
v_mov_b32 v118, 0
v_mov_b32 v119, 0
v_mov_b32 v120, 0
v_mov_b32 v121, 0
v_mov_b32 v122, 0
v_mov_b32 v123, 0
v_mov_b32 v124, 0
v_mov_b32 v125, 0
v_mov_b32 v126, 0
v_mov_b32 v127, 0
v_mov_b32_dpp v96, v244 quad_perm:[0,1,2,3] row_mask:0xf bank_mask:0x1
v_mov_b32_dpp v97, v244 row_ror:12 row_mask:0xf bank_mask:0x1
v_mov_b32_dpp v98, v244 row_ror:8 row_mask:0xf bank_mask:0x1
v_mov_b32_dpp v99, v244 row_ror:4 row_mask:0xf bank_mask:0x1
v_mov_b32_dpp v100, v244 row_ror:4 row_mask:0xf bank_mask:0x2
v_mov_b32_dpp v101, v244 quad_perm:[0,1,2,3] row_mask:0xf bank_mask:0x2
v_mov_b32_dpp v102, v244 row_ror:12 row_mask:0xf bank_mask:0x2
v_mov_b32_dpp v103, v244 row_ror:8 row_mask:0xf bank_mask:0x2
v_mov_b32_dpp v104, v244 row_ror:8 row_mask:0xf bank_mask:0x4
v_mov_b32_dpp v105, v244 row_ror:4 row_mask:0xf bank_mask:0x4
v_mov_b32_dpp v106, v244 quad_perm:[0,1,2,3] row_mask:0xf bank_mask:0x4
v_mov_b32_dpp v107, v244 row_ror:12 row_mask:0xf bank_mask:0x4
v_mov_b32_dpp v108, v244 row_ror:12 row_mask:0xf bank_mask:0x8
v_mov_b32_dpp v109, v244 row_ror:8 row_mask:0xf bank_mask:0x8
v_mov_b32_dpp v110, v244 row_ror:4 row_mask:0xf bank_mask:0x8
v_mov_b32_dpp v111, v244 quad_perm:[0,1,2,3] row_mask:0xf bank_mask:0x8
v_mov_b32_dpp v112, v245 quad_perm:[0,1,2,3] row_mask:0xf bank_mask:0x1
v_mov_b32_dpp v113, v245 row_ror:12 row_mask:0xf bank_mask:0x1
v_mov_b32_dpp v114, v245 row_ror:8 row_mask:0xf bank_mask:0x1
v_mov_b32_dpp v115, v245 row_ror:4 row_mask:0xf bank_mask:0x1
v_mov_b32_dpp v116, v245 row_ror:4 row_mask:0xf bank_mask:0x2
v_mov_b32_dpp v117, v245 quad_perm:[0,1,2,3] row_mask:0xf bank_mask:0x2
v_mov_b32_dpp v118, v245 row_ror:12 row_mask:0xf bank_mask:0x2
v_mov_b32_dpp v119, v245 row_ror:8 row_mask:0xf bank_mask:0x2
v_mov_b32_dpp v120, v245 row_ror:8 row_mask:0xf bank_mask:0x4
v_mov_b32_dpp v121, v245 row_ror:4 row_mask:0xf bank_mask:0x4
v_mov_b32_dpp v122, v245 quad_perm:[0,1,2,3] row_mask:0xf bank_mask:0x4
v_mov_b32_dpp v123, v245 row_ror:12 row_mask:0xf bank_mask:0x4
v_mov_b32_dpp v124, v245 row_ror:12 row_mask:0xf bank_mask:0x8
v_mov_b32_dpp v125, v245 row_ror:8 row_mask:0xf bank_mask:0x8
v_mov_b32_dpp v126, v245 row_ror:4 row_mask:0xf bank_mask:0x8
v_mov_b32_dpp v127, v245 quad_perm:[0,1,2,3] row_mask:0xf bank_mask:0x8
v_xor_b32 v8, 0x10000, v6
global_load_dwordx4 v[32:35], v8, s[12:13] nt
v_xor_b32 v9, 0x11000, v6
global_load_dwordx4 v[36:39], v9, s[12:13] nt
v_xor_b32 v8, 0x12000, v6
global_load_dwordx4 v[40:43], v8, s[12:13] nt
s_waitcnt vmcnt(17)
v_perm_b32 v204, v148, v144, s37
v_perm_b32 v208, v148, v144, s38
v_perm_b32 v212, v149, v145, s37
v_perm_b32 v216, v149, v145, s38
v_perm_b32 v220, v150, v146, s37
v_perm_b32 v224, v150, v146, s38
v_perm_b32 v228, v151, v147, s37
v_perm_b32 v232, v151, v147, s38
s_waitcnt vmcnt(15)
v_perm_b32 v205, v156, v152, s37
v_perm_b32 v209, v156, v152, s38
v_perm_b32 v213, v157, v153, s37
v_perm_b32 v217, v157, v153, s38
v_perm_b32 v221, v158, v154, s37
v_perm_b32 v225, v158, v154, s38
v_perm_b32 v229, v159, v155, s37
v_perm_b32 v233, v159, v155, s38
s_waitcnt vmcnt(13)
v_perm_b32 v206, v164, v160, s37
v_perm_b32 v210, v164, v160, s38
v_perm_b32 v214, v165, v161, s37
v_perm_b32 v218, v165, v161, s38
v_perm_b32 v222, v166, v162, s37
v_perm_b32 v226, v166, v162, s38
v_perm_b32 v230, v167, v163, s37
v_perm_b32 v234, v167, v163, s38
s_waitcnt vmcnt(11)
v_perm_b32 v207, v172, v168, s37
v_perm_b32 v211, v172, v168, s38
v_perm_b32 v215, v173, v169, s37
v_mfma_f32_16x16x32_bf16 v[236:239], v[96:99], v[204:207], 0
v_perm_b32 v219, v173, v169, s38
v_mfma_f32_16x16x32_bf16 v[236:239], v[100:103], v[208:211], v[236:239]
v_perm_b32 v223, v174, v170, s37
v_mfma_f32_16x16x32_bf16 v[236:239], v[104:107], v[212:215], v[236:239]
v_perm_b32 v227, v174, v170, s38
v_mfma_f32_16x16x32_bf16 v[236:239], v[108:111], v[216:219], v[236:239]
v_perm_b32 v231, v175, v171, s37
v_mfma_f32_16x16x32_bf16 v[240:243], v[96:99], v[220:223], 0
v_perm_b32 v235, v175, v171, s38
v_mfma_f32_16x16x32_bf16 v[240:243], v[100:103], v[224:227], v[240:243]
v_mfma_f32_16x16x32_bf16 v[240:243], v[104:107], v[228:231], v[240:243]
v_mfma_f32_16x16x32_bf16 v[240:243], v[108:111], v[232:235], v[240:243]
v_mov_b32_dpp v96, v246 quad_perm:[0,1,2,3] row_mask:0xf bank_mask:0x1
v_mov_b32_dpp v97, v246 row_ror:12 row_mask:0xf bank_mask:0x1
v_mov_b32_dpp v98, v246 row_ror:8 row_mask:0xf bank_mask:0x1
v_mov_b32_dpp v99, v246 row_ror:4 row_mask:0xf bank_mask:0x1
v_mov_b32_dpp v100, v246 row_ror:4 row_mask:0xf bank_mask:0x2
v_mov_b32_dpp v101, v246 quad_perm:[0,1,2,3] row_mask:0xf bank_mask:0x2
v_mov_b32_dpp v102, v246 row_ror:12 row_mask:0xf bank_mask:0x2
v_mov_b32_dpp v103, v246 row_ror:8 row_mask:0xf bank_mask:0x2
v_mov_b32_dpp v104, v246 row_ror:8 row_mask:0xf bank_mask:0x4
v_mov_b32_dpp v105, v246 row_ror:4 row_mask:0xf bank_mask:0x4
v_mov_b32_dpp v106, v246 quad_perm:[0,1,2,3] row_mask:0xf bank_mask:0x4
v_mov_b32_dpp v107, v246 row_ror:12 row_mask:0xf bank_mask:0x4
v_mov_b32_dpp v108, v246 row_ror:12 row_mask:0xf bank_mask:0x8
v_mov_b32_dpp v109, v246 row_ror:8 row_mask:0xf bank_mask:0x8
v_mov_b32_dpp v110, v246 row_ror:4 row_mask:0xf bank_mask:0x8
v_mov_b32_dpp v111, v246 quad_perm:[0,1,2,3] row_mask:0xf bank_mask:0x8
v_xor_b32 v9, 0x13000, v6
global_load_dwordx4 v[44:47], v9, s[12:13] nt
v_xor_b32 v8, 0x14000, v6
global_load_dwordx4 v[48:51], v8, s[12:13] nt
v_xor_b32 v9, 0x15000, v6
global_load_dwordx4 v[52:55], v9, s[12:13] nt
v_xor_b32 v8, 0x16000, v6
global_load_dwordx4 v[56:59], v8, s[12:13] nt
v_xor_b32 v9, 0x17000, v6
global_load_dwordx4 v[60:63], v9, s[12:13] nt
v_xor_b32 v8, 0x18000, v6
global_load_dwordx4 v[64:67], v8, s[12:13] nt
v_xor_b32 v9, 0x19000, v6
global_load_dwordx4 v[68:71], v9, s[12:13] nt
v_xor_b32 v8, 0x1a000, v6
global_load_dwordx4 v[72:75], v8, s[12:13] nt
s_waitcnt vmcnt(17)
v_perm_b32 v204, v180, v176, s37
v_perm_b32 v208, v180, v176, s38
v_perm_b32 v212, v181, v177, s37
v_perm_b32 v216, v181, v177, s38
v_perm_b32 v220, v182, v178, s37
v_perm_b32 v224, v182, v178, s38
v_perm_b32 v228, v183, v179, s37
v_perm_b32 v232, v183, v179, s38
s_waitcnt vmcnt(15)
v_perm_b32 v205, v188, v184, s37
v_perm_b32 v209, v188, v184, s38
v_perm_b32 v213, v189, v185, s37
v_perm_b32 v217, v189, v185, s38
v_perm_b32 v221, v190, v186, s37
v_perm_b32 v225, v190, v186, s38
v_perm_b32 v229, v191, v187, s37
v_perm_b32 v233, v191, v187, s38
s_waitcnt vmcnt(13)
v_perm_b32 v206, v20, v16, s37
v_perm_b32 v210, v20, v16, s38
v_perm_b32 v214, v21, v17, s37
v_perm_b32 v218, v21, v17, s38
v_perm_b32 v222, v22, v18, s37
v_perm_b32 v226, v22, v18, s38
v_perm_b32 v230, v23, v19, s37
v_perm_b32 v234, v23, v19, s38
s_waitcnt vmcnt(11)
v_perm_b32 v207, v28, v24, s37
v_perm_b32 v211, v28, v24, s38
v_perm_b32 v215, v29, v25, s37
v_mfma_f32_16x16x32_bf16 v[236:239], v[112:115], v[204:207], v[236:239]
v_perm_b32 v219, v29, v25, s38
v_mfma_f32_16x16x32_bf16 v[236:239], v[116:119], v[208:211], v[236:239]
v_perm_b32 v223, v30, v26, s37
v_mfma_f32_16x16x32_bf16 v[236:239], v[120:123], v[212:215], v[236:239]
v_perm_b32 v227, v30, v26, s38
v_mfma_f32_16x16x32_bf16 v[236:239], v[124:127], v[216:219], v[236:239]
v_perm_b32 v231, v31, v27, s37
v_mfma_f32_16x16x32_bf16 v[240:243], v[112:115], v[220:223], v[240:243]
v_perm_b32 v235, v31, v27, s38
v_mfma_f32_16x16x32_bf16 v[240:243], v[116:119], v[224:227], v[240:243]
v_mfma_f32_16x16x32_bf16 v[240:243], v[120:123], v[228:231], v[240:243]
v_mfma_f32_16x16x32_bf16 v[240:243], v[124:127], v[232:235], v[240:243]
v_mov_b32_dpp v112, v247 quad_perm:[0,1,2,3] row_mask:0xf bank_mask:0x1
v_mov_b32_dpp v113, v247 row_ror:12 row_mask:0xf bank_mask:0x1
v_mov_b32_dpp v114, v247 row_ror:8 row_mask:0xf bank_mask:0x1
v_mov_b32_dpp v115, v247 row_ror:4 row_mask:0xf bank_mask:0x1
v_mov_b32_dpp v116, v247 row_ror:4 row_mask:0xf bank_mask:0x2
v_mov_b32_dpp v117, v247 quad_perm:[0,1,2,3] row_mask:0xf bank_mask:0x2
v_mov_b32_dpp v118, v247 row_ror:12 row_mask:0xf bank_mask:0x2
v_mov_b32_dpp v119, v247 row_ror:8 row_mask:0xf bank_mask:0x2
v_mov_b32_dpp v120, v247 row_ror:8 row_mask:0xf bank_mask:0x4
v_mov_b32_dpp v121, v247 row_ror:4 row_mask:0xf bank_mask:0x4
v_mov_b32_dpp v122, v247 quad_perm:[0,1,2,3] row_mask:0xf bank_mask:0x4
v_mov_b32_dpp v123, v247 row_ror:12 row_mask:0xf bank_mask:0x4
v_mov_b32_dpp v124, v247 row_ror:12 row_mask:0xf bank_mask:0x8
v_mov_b32_dpp v125, v247 row_ror:8 row_mask:0xf bank_mask:0x8
v_mov_b32_dpp v126, v247 row_ror:4 row_mask:0xf bank_mask:0x8
v_mov_b32_dpp v127, v247 quad_perm:[0,1,2,3] row_mask:0xf bank_mask:0x8
v_xor_b32 v9, 0x1b000, v6
global_load_dwordx4 v[76:79], v9, s[12:13] nt
v_xor_b32 v8, 0x1c000, v6
global_load_dwordx4 v[80:83], v8, s[12:13] nt
v_xor_b32 v9, 0x1d000, v6
global_load_dwordx4 v[84:87], v9, s[12:13] nt
v_xor_b32 v8, 0x1e000, v6
global_load_dwordx4 v[88:91], v8, s[12:13] nt
v_xor_b32 v9, 0x1f000, v6
global_load_dwordx4 v[92:95], v9, s[12:13] nt
s_waitcnt lgkmcnt(0)
s_barrier
s_lshl_b32 s40, s3, 4
v_mov_b32 v10, s40
ds_read_b128 v[252:255], v10 offset:13312
s_lshl_b32 s40, s3, 11
v_lshl_add_u32 v12, v0, 2, s40
s_lshl_b32 s40, s3, 9
v_lshl_add_u32 v13, v0, 3, s40
s_lshl_b32 s40, s4, 15
s_lshl_b32 s41, s3, 13
s_add_u32 s40, s40, s41
s_lshl_b32 s41, s5, 6
s_add_u32 s40, s40, s41
s_add_u32 s40, s40, 589824
v_lshl_add_u32 v14, v3, 11, s40
v_lshl_add_u32 v14, v2, 2, v14
s_waitcnt lgkmcnt(0)
v_max3_f32 v10, v252, v253, v254
v_max_f32 v10, v10, v255
v_sub_f32 v252, v252, v10
v_sub_f32 v253, v253, v10
v_sub_f32 v254, v254, v10
v_sub_f32 v255, v255, v10
v_mul_f32 v252, s53, v252
v_mul_f32 v253, s53, v253
v_mul_f32 v254, s53, v254
v_mul_f32 v255, s53, v255
v_exp_f32 v252, v252
v_exp_f32 v253, v253
v_exp_f32 v254, v254
v_exp_f32 v255, v255
s_waitcnt vmcnt(14)
v_perm_b32 v204, v36, v32, s37
v_perm_b32 v208, v36, v32, s38
v_perm_b32 v212, v37, v33, s37
v_perm_b32 v216, v37, v33, s38
v_perm_b32 v220, v38, v34, s37
v_perm_b32 v224, v38, v34, s38
v_perm_b32 v228, v39, v35, s37
v_perm_b32 v232, v39, v35, s38
s_waitcnt vmcnt(12)
v_perm_b32 v205, v44, v40, s37
v_perm_b32 v209, v44, v40, s38
v_perm_b32 v213, v45, v41, s37
v_perm_b32 v217, v45, v41, s38
v_perm_b32 v221, v46, v42, s37
v_perm_b32 v225, v46, v42, s38
v_perm_b32 v229, v47, v43, s37
v_perm_b32 v233, v47, v43, s38
s_waitcnt vmcnt(10)
v_perm_b32 v206, v52, v48, s37
v_perm_b32 v210, v52, v48, s38
v_perm_b32 v214, v53, v49, s37
v_perm_b32 v218, v53, v49, s38
v_perm_b32 v222, v54, v50, s37
v_perm_b32 v226, v54, v50, s38
v_perm_b32 v230, v55, v51, s37
v_perm_b32 v234, v55, v51, s38
s_waitcnt vmcnt(8)
v_perm_b32 v207, v60, v56, s37
v_perm_b32 v211, v60, v56, s38
v_perm_b32 v215, v61, v57, s37
v_mfma_f32_16x16x32_bf16 v[236:239], v[96:99], v[204:207], v[236:239]
v_perm_b32 v219, v61, v57, s38
v_mfma_f32_16x16x32_bf16 v[236:239], v[100:103], v[208:211], v[236:239]
v_perm_b32 v223, v62, v58, s37
v_mfma_f32_16x16x32_bf16 v[236:239], v[104:107], v[212:215], v[236:239]
v_perm_b32 v227, v62, v58, s38
v_mfma_f32_16x16x32_bf16 v[236:239], v[108:111], v[216:219], v[236:239]
v_perm_b32 v231, v63, v59, s37
v_mfma_f32_16x16x32_bf16 v[240:243], v[96:99], v[220:223], v[240:243]
v_perm_b32 v235, v63, v59, s38
v_mfma_f32_16x16x32_bf16 v[240:243], v[100:103], v[224:227], v[240:243]
v_mfma_f32_16x16x32_bf16 v[240:243], v[104:107], v[228:231], v[240:243]
v_mfma_f32_16x16x32_bf16 v[240:243], v[108:111], v[232:235], v[240:243]
s_waitcnt vmcnt(6)
v_perm_b32 v204, v68, v64, s37
v_perm_b32 v208, v68, v64, s38
v_perm_b32 v212, v69, v65, s37
v_perm_b32 v216, v69, v65, s38
v_perm_b32 v220, v70, v66, s37
v_perm_b32 v224, v70, v66, s38
v_perm_b32 v228, v71, v67, s37
v_perm_b32 v232, v71, v67, s38
s_waitcnt vmcnt(4)
v_perm_b32 v205, v76, v72, s37
v_perm_b32 v209, v76, v72, s38
v_perm_b32 v213, v77, v73, s37
v_perm_b32 v217, v77, v73, s38
v_perm_b32 v221, v78, v74, s37
v_perm_b32 v225, v78, v74, s38
v_perm_b32 v229, v79, v75, s37
v_perm_b32 v233, v79, v75, s38
s_waitcnt vmcnt(2)
v_perm_b32 v206, v84, v80, s37
v_perm_b32 v210, v84, v80, s38
v_perm_b32 v214, v85, v81, s37
v_perm_b32 v218, v85, v81, s38
v_perm_b32 v222, v86, v82, s37
v_perm_b32 v226, v86, v82, s38
v_perm_b32 v230, v87, v83, s37
v_perm_b32 v234, v87, v83, s38
s_waitcnt vmcnt(0)
v_perm_b32 v207, v92, v88, s37
v_perm_b32 v211, v92, v88, s38
v_perm_b32 v215, v93, v89, s37
v_mfma_f32_16x16x32_bf16 v[236:239], v[112:115], v[204:207], v[236:239]
v_perm_b32 v219, v93, v89, s38
v_mfma_f32_16x16x32_bf16 v[236:239], v[116:119], v[208:211], v[236:239]
v_perm_b32 v223, v94, v90, s37
v_mfma_f32_16x16x32_bf16 v[236:239], v[120:123], v[212:215], v[236:239]
v_perm_b32 v227, v94, v90, s38
v_mfma_f32_16x16x32_bf16 v[236:239], v[124:127], v[216:219], v[236:239]
v_perm_b32 v231, v95, v91, s37
v_mfma_f32_16x16x32_bf16 v[240:243], v[112:115], v[220:223], v[240:243]
v_perm_b32 v235, v95, v91, s38
v_mfma_f32_16x16x32_bf16 v[240:243], v[116:119], v[224:227], v[240:243]
v_mfma_f32_16x16x32_bf16 v[240:243], v[120:123], v[228:231], v[240:243]
v_mfma_f32_16x16x32_bf16 v[240:243], v[124:127], v[232:235], v[240:243]
s_nop 7
ds_write2st64_b32 v12, v236, v240 offset0:16 offset1:17
ds_write2st64_b32 v12, v237, v241 offset0:18 offset1:19
ds_write2st64_b32 v12, v238, v242 offset0:20 offset1:21
ds_write2st64_b32 v12, v239, v243 offset0:22 offset1:23
s_waitcnt lgkmcnt(0)
s_barrier
ds_read_b64 v[204:205], v13 offset:4096
ds_read_b64 v[206:207], v13 offset:6144
ds_read_b64 v[208:209], v13 offset:8192
ds_read_b64 v[210:211], v13 offset:10240
s_cmp_eq_u32 s45, 0
s_waitcnt lgkmcnt(0)
v_pk_mul_f32 v[204:205], v[204:205], v[252:253] op_sel_hi:[1,0]
v_pk_fma_f32 v[204:205], v[206:207], v[252:253], v[204:205] op_sel:[0,1,0] op_sel_hi:[1,1,1]
v_pk_fma_f32 v[204:205], v[208:209], v[254:255], v[204:205] op_sel_hi:[1,0,1]
v_pk_fma_f32 v[204:205], v[210:211], v[254:255], v[204:205] op_sel:[0,1,0] op_sel_hi:[1,1,1]
v_cvt_pk_bf16_f32 v204, v204, v205
v_min_u32 v204, -2, v204
s_cbranch_scc0 L_slow_21
global_store_dword v14, v204, s[30:31]
s_branch L_sdone_22
L_slow_21:
global_store_dword v14, v204, s[30:31] sc1
L_sdone_22:
s_barrier
L_fin:
L_end:
s_endpgm
.section .rodata,"a"
.p2align 6
.amdhsa_kernel parallel_sum__sliding_block_cached__swiglu_ffn__decode_kernel
  .amdhsa_next_free_vgpr 256
  .amdhsa_next_free_sgpr 102
  .amdhsa_accum_offset 256
  .amdhsa_group_segment_fixed_size 0
  .amdhsa_kernarg_size 96
  .amdhsa_user_sgpr_count 2
  .amdhsa_user_sgpr_kernarg_segment_ptr 1
  .amdhsa_system_sgpr_workgroup_id_x 1
  .amdhsa_float_denorm_mode_32 3
.end_amdhsa_kernel
```
